```python
import torch

def _softmax(x, axis=-1):
    return torch.softmax(x, dim=axis)
def _gelu(x):
    return torch.nn.functional.gelu(x, approximate="tanh")
def _silu(x):
    return torch.nn.functional.silu(x)
def _sigmoid(x):
    return torch.sigmoid(x)
def _layernorm(x, axis=-1, eps=1e-5):
    m = x.mean(dim=axis, keepdim=True)
    v = x.var(dim=axis, keepdim=True, unbiased=False)
    return (x - m) / torch.sqrt(v + eps)
def _scatter_add(tgt, idx, src, axis=0):
    return tgt.clone().index_add_(axis, idx, src)
def _segment_sum(src, seg, n):
    out = torch.zeros((n,) + src.shape[1:], dtype=src.dtype)
    return out.index_add_(0, seg, src)
def _pad(x, pw):
    flat = tuple(v for pair in reversed(pw) for v in pair)
    return torch.nn.functional.pad(x, flat)

kernel_name = 'standalone__gqa_softmax__near_ridge'

def setup_inputs():

    _w = (lambda a: (lambda t: t.to(torch.bfloat16) if t.is_floating_point() else t)(torch.as_tensor(a)))
    B, Hq, Hkv, Sq, Sk, D = 8, 32, 8, 64, 1024, 128
    return {
        "q": _w((lambda *s: torch.randn(*s, dtype=torch.bfloat16) * 0.8)(B, Hq, Sq, D)),
        "k": _w((lambda *s: torch.randn(*s, dtype=torch.bfloat16) * 0.8)(B, Hkv, Sk, D)),
        "v": _w((lambda *s: torch.randn(*s, dtype=torch.bfloat16) * 0.05)(B, Hkv, Sk, D)),
    }

def reference(q, k, v):
    B, Hq, Sq, D = q.shape
    Hkv = k.shape[1]
    rep = Hq // Hkv
    k = (lambda x, n, axis: torch.repeat_interleave(x, n, dim=axis))(k, rep, axis=1)
    v = (lambda x, n, axis: torch.repeat_interleave(x, n, dim=axis))(v, rep, axis=1)
    scale = D ** -0.5
    scores = torch.einsum("bhqd,bhkd->bhqk", q, k) * scale
    p = _softmax(scores, axis=-1)
    return torch.einsum("bhqk,bhkd->bhqd", p, v)
```

```asm
; @launch grid=(256,1,1) block=(512,1,1) lds=163840
.amdgcn_target "amdgcn-amd-amdhsa--gfx950"
.text
.globl standalone__gqa_softmax__near_ridge_kernel
.p2align 8
.type standalone__gqa_softmax__near_ridge_kernel,@function
standalone__gqa_softmax__near_ridge_kernel:
    s_load_dwordx8 s[4:11], s[0:1], 0
    s_cmpk_ge_u32 s2, 256
    s_cbranch_scc1 L_end
    v_lshlrev_b32 v28, 4, v0
    s_getpc_b64 s[50:51]
    v_mov_b32 v41, s51
    v_add_co_u32 v40, vcc, s50, v28
    v_addc_co_u32 v41, vcc, 0, v41, vcc
    global_load_dword v42, v[40:41], off
    v_lshrrev_b32 v1, 6, v0
    s_and_b32 s12, s2, 7
    v_readfirstlane_b32 s3, v1
    s_lshr_b32 s13, s2, 5
    s_lshl3_add_u32 s12, s13, s12
    s_bfe_u32 s13, s2, 0x20003
    s_lshl2_add_u32 s13, s12, s13
    s_lshl_b32 s13, s13, 14
    s_movk_i32 s26, 0x4000
    s_mov_b32 s27, 0x20000
    s_movk_i32 s38, 0x2000
    v_and_b32 v14, 0x3ff, v28
    v_and_b32 v24, 48, v0
    v_xor_b32 v14, v14, v24
    s_and_b32 s46, s3, 3
    s_lshr_b32 s47, s3, 2
    s_lshl2_add_u32 s14, s12, s46
    s_lshl4_add_u32 s14, s14, s47
    s_lshl_b32 s14, s14, 12
    s_mul_i32 s32, s46, 36864
    s_addk_i32 s32, 16384
    s_lshl_b32 s39, s47, 12
    s_add_u32 m0, s32, s39
    s_lshl_b32 s18, s26, 2
    s_mov_b32 s19, s27
    v_xor_b32 v15, 64, v14
    v_xor_b32 v16, 0x80, v14
    v_xor_b32 v17, 64, v16
    s_waitcnt lgkmcnt(0)
    s_add_u32 s24, s4, s13
    s_addc_u32 s25, s5, 0
    buffer_load_dwordx4 v[32:35], v28, s[24:27], 0 offen
    buffer_load_dwordx4 v[36:39], v28, s[24:27], s38 offen
    s_add_u32 s16, s6, s14
    s_addc_u32 s17, s7, 0
    buffer_load_dwordx4 v14, s[16:19], 0 offen offset:0  lds
    buffer_load_dwordx4 v15, s[16:19], 0 offen offset:1024  lds
    buffer_load_dwordx4 v16, s[16:19], 0 offen offset:2048  lds
    buffer_load_dwordx4 v17, s[16:19], 0 offen offset:3072  lds
    s_mov_b32 s45, m0
    v_bfe_u32 v24, v0, 4, 2
    v_and_b32 v25, 15, v0
    v_lshlrev_b32 v26, 8, v24
    s_mov_b32 s52, 0x76534210
    s_mov_b32 s53, 0x75642310
    s_bitcmp1_b32 s2, 3
    s_cmov_b32 s52, 0x76453210
    s_cmov_b32 s53, 0x67542310
    s_bitcmp1_b32 s2, 4
    s_cmov_b32 s52, s53
    v_and_b32 v29, 0xf0, v0
    v_xor_b32 v29, v29, v28
    v_and_b32 v0, 63, v0
    s_add_u32 s20, s8, s14
    s_addc_u32 s21, s9, 0
    s_mov_b32 s22, 61440
    s_mov_b32 s23, 0x20000
    v_lshlrev_b32 v27, 2, v24
    v_xor_b32 v27, v27, v25
    v_lshl_add_u32 v18, v27, 4, v26
    v_and_b32 v24, 31, v0
    v_lshrrev_b32 v26, 5, v0
    v_xor_b32 v25, v25, v26
    v_lshlrev_b32 v24, 8, v24
    v_lshl_add_u32 v24, v25, 4, v24
    s_lshl_b32 s48, s47, 13
    v_add_u32 v2, s32, v24
    v_xor_b32 v64, s48, v24
    v_xor_b32 v3, 32, v2
    v_xor_b32 v65, 32, v64
    v_xor_b32 v4, 64, v2
    v_xor_b32 v66, 64, v64
    v_xor_b32 v5, 96, v2
    v_xor_b32 v67, 96, v64
    v_xor_b32 v6, 128, v2
    v_xor_b32 v68, 128, v64
    v_xor_b32 v7, 160, v2
    v_xor_b32 v69, 160, v64
    v_xor_b32 v8, 192, v2
    v_xor_b32 v70, 192, v64
    v_xor_b32 v9, 224, v2
    v_xor_b32 v71, 224, v64
    v_bfe_u32 v24, v0, 2, 2
    v_lshl_add_u32 v25, v26, 2, v24
    v_lshlrev_b32 v25, 8, v25
    v_and_b32 v26, 1, v0
    v_lshl_add_u32 v25, v26, 4, v25
    v_and_b32 v26, 2, v0
    v_lshl_add_u32 v25, v26, 2, v25
    v_bfe_u32 v26, v0, 4, 1
    v_lshl_add_u32 v25, v26, 5, v25
    v_add_u32 v25, s32, v25
    v_xor_b32 v24, s46, v24
    v_lshl_add_u32 v10, v24, 6, v25
    v_xor_b32 v11, 64, v10
    v_xor_b32 v12, 128, v10
    v_xor_b32 v13, 192, v10
    s_add_u32 s28, s10, s13
    s_addc_u32 s29, s11, 0
    s_mov_b32 s30, 16384
    s_mov_b32 s31, 0x20000
    s_mov_b32 s33, 0x3e0293ee
    s_mov_b32 s34, 0x44800000
    s_mov_b32 s35, 0xffff0000
    v_bfe_u32 v24, v0, 3, 2
    v_bfe_u32 v25, v0, 1, 1
    v_lshl_add_u32 v24, v24, 1, v25
    v_lshrrev_b32 v25, 3, v0
    v_xor_b32 v25, v25, v0
    v_and_b32 v25, 4, v25
    v_lshl_add_u32 v24, v25, 1, v24
    v_and_b32 v25, 1, v0
    v_lshlrev_b32 v25, 4, v25
    s_movk_i32 s39, 0x3f80
    v_lshlrev_b32 v25, v25, s39
    v_cmp_eq_u32 vcc, 0, v24
    s_nop 1
    v_cndmask_b32 v48, 0, v25, vcc
    v_cmp_eq_u32 vcc, 1, v24
    s_nop 1
    v_cndmask_b32 v49, 0, v25, vcc
    v_cmp_eq_u32 vcc, 2, v24
    s_nop 1
    v_cndmask_b32 v50, 0, v25, vcc
    v_cmp_eq_u32 vcc, 3, v24
    s_nop 1
    v_cndmask_b32 v51, 0, v25, vcc
    v_cmp_eq_u32 vcc, 4, v24
    s_nop 1
    v_cndmask_b32 v52, 0, v25, vcc
    v_cmp_eq_u32 vcc, 5, v24
    s_nop 1
    v_cndmask_b32 v53, 0, v25, vcc
    v_cmp_eq_u32 vcc, 6, v24
    s_nop 1
    v_cndmask_b32 v54, 0, v25, vcc
    v_cmp_eq_u32 vcc, 7, v24
    s_nop 1
    v_cndmask_b32 v55, 0, v25, vcc
    v_lshl_add_u32 v26, v0, 4, s32
    ds_write_b128 v26, v[48:51] offset:34816
    ds_write_b128 v26, v[52:55] offset:35840
    v_and_b32 v24, 31, v0
    s_lshl_b32 s39, s47, 9
    v_lshl_add_u32 v19, v24, 4, s39
    v_lshl_add_u32 v1, s46, 2, v19
    s_waitcnt vmcnt(5)
    v_lshlrev_b32 v40, 16, v32
    v_and_b32 v41, s35, v32
    v_lshlrev_b32 v42, 16, v33
    v_and_b32 v43, s35, v33
    v_lshlrev_b32 v44, 16, v34
    v_and_b32 v45, s35, v34
    v_lshlrev_b32 v46, 16, v35
    v_and_b32 v47, s35, v35
    s_add_u32 m0, s45, 8192
    s_bfe_u32 s37, s52, 0x30004
    s_lshl_b32 s37, s37, 13
    buffer_load_dwordx4 v14, s[16:19], s37 offen offset:0  lds
    v_mul_f32 v40, s33, v40
    v_mul_f32 v41, s33, v41
    v_mul_f32 v42, s33, v42
    v_mul_f32 v43, s33, v43
    v_mul_f32 v44, s33, v44
    v_mul_f32 v45, s33, v45
    v_mul_f32 v46, s33, v46
    v_mul_f32 v47, s33, v47
    v_cvt_pk_bf16_f32 v32, v40, v41
    v_cvt_pk_bf16_f32 v33, v42, v43
    v_cvt_pk_bf16_f32 v34, v44, v45
    v_cvt_pk_bf16_f32 v35, v46, v47
    ds_write_b128 v29, v[32:35] offset:0
    buffer_load_dwordx4 v15, s[16:19], s37 offen offset:1024  lds
    s_waitcnt vmcnt(6)
    v_lshlrev_b32 v40, 16, v36
    v_and_b32 v41, s35, v36
    v_lshlrev_b32 v42, 16, v37
    v_and_b32 v43, s35, v37
    v_lshlrev_b32 v44, 16, v38
    v_and_b32 v45, s35, v38
    v_lshlrev_b32 v46, 16, v39
    v_and_b32 v47, s35, v39
    buffer_load_dwordx4 v16, s[16:19], s37 offen offset:2048  lds
    v_mul_f32 v40, s33, v40
    v_mul_f32 v41, s33, v41
    v_mul_f32 v42, s33, v42
    v_mul_f32 v43, s33, v43
    v_mul_f32 v44, s33, v44
    v_mul_f32 v45, s33, v45
    v_mul_f32 v46, s33, v46
    v_mul_f32 v47, s33, v47
    v_cvt_pk_bf16_f32 v36, v40, v41
    v_cvt_pk_bf16_f32 v37, v42, v43
    v_cvt_pk_bf16_f32 v38, v44, v45
    v_cvt_pk_bf16_f32 v39, v46, v47
    ds_write_b128 v29, v[36:39] offset:8192
    buffer_load_dwordx4 v17, s[16:19], s37 offen offset:3072  lds
    s_waitcnt vmcnt(4) lgkmcnt(0)
    s_barrier
    ds_read_b128 a[0:3], v64
    ds_read_b128 a[32:35], v2 offset:0
    ds_read_b128 a[4:7], v65
    ds_read_b128 a[36:39], v3 offset:0
    ds_read_b128 a[8:11], v66
    ds_read_b128 a[40:43], v4 offset:0
    ds_read_b128 a[12:15], v67
    ds_read_b128 a[44:47], v5 offset:0
    ds_read_b128 a[16:19], v68
    ds_read_b128 a[48:51], v6 offset:0
    ds_read_b128 a[20:23], v69
    ds_read_b128 a[52:55], v7 offset:0
    ds_read_b128 a[24:27], v70
    ds_read_b128 a[56:59], v8 offset:0
    ds_read_b128 a[28:31], v71
    ds_read_b128 a[60:63], v9 offset:0
    s_add_u32 m0, s45, 16384
    s_bfe_u32 s37, s52, 0x30000
    s_lshl_b32 s37, s37, 13
    buffer_load_dwordx4 v18, s[20:23], s37 offen offset:0  lds
    s_waitcnt lgkmcnt(14)
    v_mfma_f32_32x32x16_bf16 v[48:63], a[32:35], a[0:3], 0
    buffer_load_dwordx4 v18, s[20:23], s37 offen offset:1024  lds
    s_waitcnt lgkmcnt(12)
    v_mfma_f32_32x32x16_bf16 v[48:63], a[36:39], a[4:7], v[48:63]
    buffer_load_dwordx4 v18, s[20:23], s37 offen offset:2048  lds
    s_waitcnt lgkmcnt(10)
    v_mfma_f32_32x32x16_bf16 v[48:63], a[40:43], a[8:11], v[48:63]
    buffer_load_dwordx4 v18, s[20:23], s37 offen offset:3072  lds
    s_waitcnt lgkmcnt(8)
    v_mfma_f32_32x32x16_bf16 v[48:63], a[44:47], a[12:15], v[48:63]
    s_add_u32 m0, s45, 24576
    s_bfe_u32 s37, s52, 0x30008
    s_lshl_b32 s37, s37, 13
    buffer_load_dwordx4 v14, s[16:19], s37 offen offset:0  lds
    s_waitcnt lgkmcnt(6)
    v_mfma_f32_32x32x16_bf16 v[48:63], a[48:51], a[16:19], v[48:63]
    buffer_load_dwordx4 v15, s[16:19], s37 offen offset:1024  lds
    s_waitcnt lgkmcnt(4)
    v_mfma_f32_32x32x16_bf16 v[48:63], a[52:55], a[20:23], v[48:63]
    buffer_load_dwordx4 v16, s[16:19], s37 offen offset:2048  lds
    s_waitcnt lgkmcnt(2)
    v_mfma_f32_32x32x16_bf16 v[48:63], a[56:59], a[24:27], v[48:63]
    buffer_load_dwordx4 v17, s[16:19], s37 offen offset:3072  lds
    s_waitcnt lgkmcnt(0)
    v_mfma_f32_32x32x16_bf16 v[48:63], a[60:63], a[28:31], v[48:63]
    s_nop 11
    v_max3_f32 v28, v48, v49, v50
    v_max3_f32 v29, v51, v52, v53
    v_max3_f32 v28, v28, v54, v55
    v_max3_f32 v29, v29, v56, v57
    v_max3_f32 v28, v28, v58, v59
    v_max3_f32 v29, v29, v60, v61
    v_max3_f32 v28, v28, v62, v63
    v_max_f32 v28, v28, v29
    v_mov_b32 v29, v28
    s_nop 1
    v_permlane32_swap_b32 v29, v28
    v_max_f32 v28, v28, v29
    ds_write_b32 v1, v28 offset:50176
    s_waitcnt vmcnt(8) lgkmcnt(0)
    s_barrier
    ds_read_b128 v[28:31], v19 offset:50176
    ds_read_b128 a[32:35], v2 offset:8192
    ds_read_b128 a[36:39], v3 offset:8192
    ds_read_b128 a[40:43], v4 offset:8192
    ds_read_b128 a[44:47], v5 offset:8192
    ds_read_b128 a[48:51], v6 offset:8192
    ds_read_b128 a[52:55], v7 offset:8192
    ds_read_b128 a[56:59], v8 offset:8192
    ds_read_b128 a[60:63], v9 offset:8192
    s_waitcnt lgkmcnt(8)
    v_max3_f32 v28, v28, v29, v30
    v_max_f32 v28, v28, v31
    v_sub_f32 v144, 0, v28
    v_add_f32 v48, v48, v144
    v_add_f32 v49, v49, v144
    v_exp_f32 v24, v48
    v_exp_f32 v25, v49
    v_add_f32 v50, v50, v144
    v_add_f32 v51, v51, v144
    v_exp_f32 v26, v50
    v_add_f32 v22, v24, v25
    v_exp_f32 v27, v51
    v_cvt_pk_bf16_f32 v32, v24, v25
    v_add_f32 v52, v52, v144
    v_add_f32 v53, v53, v144
    s_add_u32 m0, s45, 0
    s_bfe_u32 s37, s52, 0x30004
    s_lshl_b32 s37, s37, 13
    buffer_load_dwordx4 v18, s[20:23], s37 offen offset:0  lds
    v_exp_f32 v24, v52
    v_add_f32 v22, v22, v26
    v_add_f32 v22, v22, v27
    v_exp_f32 v25, v53
    v_cvt_pk_bf16_f32 v33, v26, v27
    v_add_f32 v54, v54, v144
    v_add_f32 v55, v55, v144
    v_exp_f32 v26, v54
    v_add_f32 v22, v22, v24
    v_add_f32 v22, v22, v25
    v_exp_f32 v27, v55
    v_cvt_pk_bf16_f32 v34, v24, v25
    buffer_load_dwordx4 v18, s[20:23], s37 offen offset:1024  lds
    v_add_f32 v56, v56, v144
    v_add_f32 v57, v57, v144
    v_exp_f32 v24, v56
    v_add_f32 v22, v22, v26
    v_add_f32 v22, v22, v27
    v_exp_f32 v25, v57
    v_cvt_pk_bf16_f32 v35, v26, v27
    v_add_f32 v22, v22, v24
    v_add_f32 v22, v22, v25
    v_cvt_pk_bf16_f32 v36, v24, v25
    v_mov_b32 v145, v144
    v_mov_b32 v146, v144
    buffer_load_dwordx4 v18, s[20:23], s37 offen offset:2048  lds
    v_mov_b32 v147, v144
    v_mov_b32 v148, v144
    v_mov_b32 v149, v144
    v_mov_b32 v150, v144
    v_mov_b32 v151, v144
    v_mov_b32 v152, v144
    v_mov_b32 v153, v144
    v_mov_b32 v154, v144
    v_mov_b32 v155, v144
    v_mov_b32 v156, v144
    v_mov_b32 v157, v144
    v_mov_b32 v158, v144
    buffer_load_dwordx4 v18, s[20:23], s37 offen offset:3072  lds
    v_mov_b32 v159, v144
    s_waitcnt vmcnt(8) lgkmcnt(0)
    s_barrier
    v_mfma_f32_32x32x16_bf16 v[64:79], a[32:35], a[0:3], v[144:159]
    v_add_f32 v58, v58, v144
    ds_read_b64_tr_b16 a[64:65], v10 offset:16384
    v_add_f32 v59, v59, v144
    ds_read_b64_tr_b16 a[66:67], v10 offset:18432
    v_exp_f32 v26, v58
    ds_read_b64_tr_b16 a[72:73], v11 offset:16384
    s_add_u32 m0, s45, 8192
    s_bfe_u32 s37, s52, 0x3000c
    s_lshl_b32 s37, s37, 13
    buffer_load_dwordx4 v14, s[16:19], s37 offen offset:0  lds
    ds_read_b64_tr_b16 a[74:75], v11 offset:18432
    v_exp_f32 v27, v59
    v_mfma_f32_32x32x16_bf16 v[64:79], a[36:39], a[4:7], v[64:79]
    ds_read_b64_tr_b16 a[80:81], v12 offset:16384
    v_add_f32 v60, v60, v144
    ds_read_b64_tr_b16 a[82:83], v12 offset:18432
    v_add_f32 v61, v61, v144
    ds_read_b64_tr_b16 a[88:89], v13 offset:16384
    v_exp_f32 v24, v60
    v_mfma_f32_32x32x16_bf16 v[64:79], a[40:43], a[8:11], v[64:79]
    ds_read_b64_tr_b16 a[90:91], v13 offset:18432
    ds_read_b64_tr_b16 a[68:69], v10 offset:20480
    v_add_f32 v22, v22, v26
    v_add_f32 v22, v22, v27
    ds_read_b64_tr_b16 a[70:71], v10 offset:22528
    v_exp_f32 v25, v61
    v_mfma_f32_32x32x16_bf16 v[64:79], a[44:47], a[12:15], v[64:79]
    ds_read_b64_tr_b16 a[76:77], v11 offset:20480
    ds_read_b64_tr_b16 a[78:79], v11 offset:22528
    v_cvt_pk_bf16_f32 v37, v26, v27
    buffer_load_dwordx4 v15, s[16:19], s37 offen offset:1024  lds
    ds_read_b64_tr_b16 a[84:85], v12 offset:20480
    v_add_f32 v62, v62, v144
    v_add_f32 v63, v63, v144
    ds_read_b64_tr_b16 a[86:87], v12 offset:22528
    v_mfma_f32_32x32x16_bf16 v[64:79], a[48:51], a[16:19], v[64:79]
    v_exp_f32 v26, v62
    ds_read_b64_tr_b16 a[92:93], v13 offset:20480
    ds_read_b64_tr_b16 a[94:95], v13 offset:22528
    v_add_f32 v22, v22, v24
    buffer_load_dwordx4 v16, s[16:19], s37 offen offset:2048  lds
    v_add_f32 v22, v22, v25
    v_mfma_f32_32x32x16_bf16 v[64:79], a[52:55], a[20:23], v[64:79]
    v_exp_f32 v27, v63
    v_cvt_pk_bf16_f32 v38, v24, v25
    buffer_load_dwordx4 v17, s[16:19], s37 offen offset:3072  lds
    v_add_f32 v22, v22, v26
    v_mfma_f32_32x32x16_bf16 v[64:79], a[56:59], a[24:27], v[64:79]
    v_add_f32 v22, v22, v27
    v_cvt_pk_bf16_f32 v39, v26, v27
    v_mfma_f32_32x32x16_bf16 v[64:79], a[60:63], a[28:31], v[64:79]
    v_mov_b32 v21, v22
    s_waitcnt vmcnt(8) lgkmcnt(0)
    s_barrier
    v_mfma_f32_32x32x16_bf16 v[80:95], a[64:67], v[32:35], 0
    ds_read_b128 a[32:35], v2 offset:24576
    ds_read_b128 a[36:39], v3 offset:24576
    s_add_u32 m0, s45, 16384
    s_bfe_u32 s37, s52, 0x30008
    s_lshl_b32 s37, s37, 13
    buffer_load_dwordx4 v18, s[20:23], s37 offen offset:0  lds
    ds_read_b128 a[40:43], v4 offset:24576
    v_mfma_f32_32x32x16_bf16 v[96:111], a[72:75], v[32:35], 0
    ds_read_b128 a[44:47], v5 offset:24576
    v_exp_f32 v24, v64
    v_exp_f32 v25, v65
    ds_read_b128 a[48:51], v6 offset:24576
    v_mfma_f32_32x32x16_bf16 v[112:127], a[80:83], v[32:35], 0
    v_exp_f32 v26, v66
    ds_read_b128 a[52:55], v7 offset:24576
    v_add_f32 v22, v24, v25
    v_exp_f32 v27, v67
    ds_read_b128 a[56:59], v8 offset:24576
    v_cvt_pk_bf16_f32 v40, v24, v25
    v_mfma_f32_32x32x16_bf16 v[128:143], a[88:91], v[32:35], 0
    v_exp_f32 v24, v68
    ds_read_b128 a[60:63], v9 offset:24576
    v_add_f32 v22, v22, v26
    v_add_f32 v22, v22, v27
    buffer_load_dwordx4 v18, s[20:23], s37 offen offset:1024  lds
    v_exp_f32 v25, v69
    v_mfma_f32_32x32x16_bf16 v[80:95], a[68:71], v[36:39], v[80:95]
    v_cvt_pk_bf16_f32 v41, v26, v27
    v_exp_f32 v26, v70
    v_add_f32 v22, v22, v24
    v_add_f32 v22, v22, v25
    buffer_load_dwordx4 v18, s[20:23], s37 offen offset:2048  lds
    v_exp_f32 v27, v71
    v_mfma_f32_32x32x16_bf16 v[96:111], a[76:79], v[36:39], v[96:111]
    v_cvt_pk_bf16_f32 v42, v24, v25
    v_exp_f32 v24, v72
    v_add_f32 v22, v22, v26
    v_add_f32 v22, v22, v27
    buffer_load_dwordx4 v18, s[20:23], s37 offen offset:3072  lds
    v_mfma_f32_32x32x16_bf16 v[112:127], a[84:87], v[36:39], v[112:127]
    v_exp_f32 v25, v73
    v_cvt_pk_bf16_f32 v43, v26, v27
    v_add_f32 v22, v22, v24
    v_add_f32 v22, v22, v25
    v_cvt_pk_bf16_f32 v44, v24, v25
    v_mfma_f32_32x32x16_bf16 v[128:143], a[92:95], v[36:39], v[128:143]
    s_waitcnt vmcnt(8) lgkmcnt(0)
    s_barrier
    v_mfma_f32_32x32x16_bf16 v[48:63], a[32:35], a[0:3], v[144:159]
    v_exp_f32 v26, v74
    ds_read_b64_tr_b16 a[64:65], v10 offset:0
    ds_read_b64_tr_b16 a[66:67], v10 offset:2048
    ds_read_b64_tr_b16 a[72:73], v11 offset:0
    v_exp_f32 v27, v75
    s_add_u32 m0, s45, 24576
    s_bfe_u32 s37, s52, 0x30010
    s_lshl_b32 s37, s37, 13
    buffer_load_dwordx4 v14, s[16:19], s37 offen offset:0  lds
    ds_read_b64_tr_b16 a[74:75], v11 offset:2048
    v_mfma_f32_32x32x16_bf16 v[48:63], a[36:39], a[4:7], v[48:63]
    ds_read_b64_tr_b16 a[80:81], v12 offset:0
    v_exp_f32 v24, v76
    ds_read_b64_tr_b16 a[82:83], v12 offset:2048
    ds_read_b64_tr_b16 a[88:89], v13 offset:0
    v_add_f32 v22, v22, v26
    v_mfma_f32_32x32x16_bf16 v[48:63], a[40:43], a[8:11], v[48:63]
    ds_read_b64_tr_b16 a[90:91], v13 offset:2048
    v_add_f32 v22, v22, v27
    ds_read_b64_tr_b16 a[68:69], v10 offset:4096
    v_exp_f32 v25, v77
    ds_read_b64_tr_b16 a[70:71], v10 offset:6144
    v_mfma_f32_32x32x16_bf16 v[48:63], a[44:47], a[12:15], v[48:63]
    ds_read_b64_tr_b16 a[76:77], v11 offset:4096
    v_cvt_pk_bf16_f32 v45, v26, v27
    ds_read_b64_tr_b16 a[78:79], v11 offset:6144
    v_exp_f32 v26, v78
    buffer_load_dwordx4 v15, s[16:19], s37 offen offset:1024  lds
    ds_read_b64_tr_b16 a[84:85], v12 offset:4096
    ds_read_b64_tr_b16 a[86:87], v12 offset:6144
    v_mfma_f32_32x32x16_bf16 v[48:63], a[48:51], a[16:19], v[48:63]
    v_add_f32 v22, v22, v24
    ds_read_b64_tr_b16 a[92:93], v13 offset:4096
    v_add_f32 v22, v22, v25
    ds_read_b64_tr_b16 a[94:95], v13 offset:6144
    buffer_load_dwordx4 v16, s[16:19], s37 offen offset:2048  lds
    v_exp_f32 v27, v79
    v_mfma_f32_32x32x16_bf16 v[48:63], a[52:55], a[20:23], v[48:63]
    v_cvt_pk_bf16_f32 v46, v24, v25
    v_add_f32 v22, v22, v26
    buffer_load_dwordx4 v17, s[16:19], s37 offen offset:3072  lds
    v_mfma_f32_32x32x16_bf16 v[48:63], a[56:59], a[24:27], v[48:63]
    v_add_f32 v22, v22, v27
    v_cvt_pk_bf16_f32 v47, v26, v27
    v_mfma_f32_32x32x16_bf16 v[48:63], a[60:63], a[28:31], v[48:63]
    v_cmp_lt_f32 vcc, s34, v22
    s_cbranch_vccnz L_r1
    L_b1:
    v_add_f32 v21, v21, v22
    s_waitcnt vmcnt(8) lgkmcnt(0)
    s_barrier
    v_mfma_f32_32x32x16_bf16 v[80:95], a[64:67], v[40:43], v[80:95]
    ds_read_b128 a[32:35], v2 offset:8192
    ds_read_b128 a[36:39], v3 offset:8192
    s_add_u32 m0, s45, 0
    s_bfe_u32 s37, s52, 0x3000c
    s_lshl_b32 s37, s37, 13
    buffer_load_dwordx4 v18, s[20:23], s37 offen offset:0  lds
    ds_read_b128 a[40:43], v4 offset:8192
    v_mfma_f32_32x32x16_bf16 v[96:111], a[72:75], v[40:43], v[96:111]
    ds_read_b128 a[44:47], v5 offset:8192
    v_exp_f32 v24, v48
    v_exp_f32 v25, v49
    ds_read_b128 a[48:51], v6 offset:8192
    v_mfma_f32_32x32x16_bf16 v[112:127], a[80:83], v[40:43], v[112:127]
    v_exp_f32 v26, v50
    ds_read_b128 a[52:55], v7 offset:8192
    v_add_f32 v22, v24, v25
    v_exp_f32 v27, v51
    ds_read_b128 a[56:59], v8 offset:8192
    v_cvt_pk_bf16_f32 v32, v24, v25
    v_mfma_f32_32x32x16_bf16 v[128:143], a[88:91], v[40:43], v[128:143]
    v_exp_f32 v24, v52
    ds_read_b128 a[60:63], v9 offset:8192
    v_add_f32 v22, v22, v26
    v_add_f32 v22, v22, v27
    buffer_load_dwordx4 v18, s[20:23], s37 offen offset:1024  lds
    v_exp_f32 v25, v53
    v_mfma_f32_32x32x16_bf16 v[80:95], a[68:71], v[44:47], v[80:95]
    v_cvt_pk_bf16_f32 v33, v26, v27
    v_exp_f32 v26, v54
    v_add_f32 v22, v22, v24
    v_add_f32 v22, v22, v25
    buffer_load_dwordx4 v18, s[20:23], s37 offen offset:2048  lds
    v_exp_f32 v27, v55
    v_mfma_f32_32x32x16_bf16 v[96:111], a[76:79], v[44:47], v[96:111]
    v_cvt_pk_bf16_f32 v34, v24, v25
    v_exp_f32 v24, v56
    v_add_f32 v22, v22, v26
    v_add_f32 v22, v22, v27
    buffer_load_dwordx4 v18, s[20:23], s37 offen offset:3072  lds
    v_mfma_f32_32x32x16_bf16 v[112:127], a[84:87], v[44:47], v[112:127]
    v_exp_f32 v25, v57
    v_cvt_pk_bf16_f32 v35, v26, v27
    v_add_f32 v22, v22, v24
    v_add_f32 v22, v22, v25
    v_cvt_pk_bf16_f32 v36, v24, v25
    v_mfma_f32_32x32x16_bf16 v[128:143], a[92:95], v[44:47], v[128:143]
    s_waitcnt vmcnt(8) lgkmcnt(0)
    s_barrier
    v_mfma_f32_32x32x16_bf16 v[64:79], a[32:35], a[0:3], v[144:159]
    v_exp_f32 v26, v58
    ds_read_b64_tr_b16 a[64:65], v10 offset:16384
    ds_read_b64_tr_b16 a[66:67], v10 offset:18432
    ds_read_b64_tr_b16 a[72:73], v11 offset:16384
    v_exp_f32 v27, v59
    s_add_u32 m0, s45, 8192
    s_bfe_u32 s37, s52, 0x30014
    s_lshl_b32 s37, s37, 13
    buffer_load_dwordx4 v14, s[16:19], s37 offen offset:0  lds
    ds_read_b64_tr_b16 a[74:75], v11 offset:18432
    v_mfma_f32_32x32x16_bf16 v[64:79], a[36:39], a[4:7], v[64:79]
    ds_read_b64_tr_b16 a[80:81], v12 offset:16384
    v_exp_f32 v24, v60
    ds_read_b64_tr_b16 a[82:83], v12 offset:18432
    ds_read_b64_tr_b16 a[88:89], v13 offset:16384
    v_add_f32 v22, v22, v26
    v_mfma_f32_32x32x16_bf16 v[64:79], a[40:43], a[8:11], v[64:79]
    ds_read_b64_tr_b16 a[90:91], v13 offset:18432
    v_add_f32 v22, v22, v27
    ds_read_b64_tr_b16 a[68:69], v10 offset:20480
    v_exp_f32 v25, v61
    ds_read_b64_tr_b16 a[70:71], v10 offset:22528
    v_mfma_f32_32x32x16_bf16 v[64:79], a[44:47], a[12:15], v[64:79]
    ds_read_b64_tr_b16 a[76:77], v11 offset:20480
    v_cvt_pk_bf16_f32 v37, v26, v27
    ds_read_b64_tr_b16 a[78:79], v11 offset:22528
    v_exp_f32 v26, v62
    buffer_load_dwordx4 v15, s[16:19], s37 offen offset:1024  lds
    ds_read_b64_tr_b16 a[84:85], v12 offset:20480
    ds_read_b64_tr_b16 a[86:87], v12 offset:22528
    v_mfma_f32_32x32x16_bf16 v[64:79], a[48:51], a[16:19], v[64:79]
    v_add_f32 v22, v22, v24
    ds_read_b64_tr_b16 a[92:93], v13 offset:20480
    v_add_f32 v22, v22, v25
    ds_read_b64_tr_b16 a[94:95], v13 offset:22528
    buffer_load_dwordx4 v16, s[16:19], s37 offen offset:2048  lds
    v_exp_f32 v27, v63
    v_mfma_f32_32x32x16_bf16 v[64:79], a[52:55], a[20:23], v[64:79]
    v_cvt_pk_bf16_f32 v38, v24, v25
    v_add_f32 v22, v22, v26
    buffer_load_dwordx4 v17, s[16:19], s37 offen offset:3072  lds
    v_mfma_f32_32x32x16_bf16 v[64:79], a[56:59], a[24:27], v[64:79]
    v_add_f32 v22, v22, v27
    v_cvt_pk_bf16_f32 v39, v26, v27
    v_mfma_f32_32x32x16_bf16 v[64:79], a[60:63], a[28:31], v[64:79]
    v_cmp_lt_f32 vcc, s34, v22
    s_cbranch_vccnz L_r2
    L_b2:
    v_add_f32 v21, v21, v22
    s_waitcnt vmcnt(8) lgkmcnt(0)
    s_barrier
    v_mfma_f32_32x32x16_bf16 v[80:95], a[64:67], v[32:35], v[80:95]
    ds_read_b128 a[32:35], v2 offset:24576
    ds_read_b128 a[36:39], v3 offset:24576
    s_add_u32 m0, s45, 16384
    s_bfe_u32 s37, s52, 0x30010
    s_lshl_b32 s37, s37, 13
    buffer_load_dwordx4 v18, s[20:23], s37 offen offset:0  lds
    ds_read_b128 a[40:43], v4 offset:24576
    v_mfma_f32_32x32x16_bf16 v[96:111], a[72:75], v[32:35], v[96:111]
    ds_read_b128 a[44:47], v5 offset:24576
    v_exp_f32 v24, v64
    v_exp_f32 v25, v65
    ds_read_b128 a[48:51], v6 offset:24576
    v_mfma_f32_32x32x16_bf16 v[112:127], a[80:83], v[32:35], v[112:127]
    v_exp_f32 v26, v66
    ds_read_b128 a[52:55], v7 offset:24576
    v_add_f32 v22, v24, v25
    v_exp_f32 v27, v67
    ds_read_b128 a[56:59], v8 offset:24576
    v_cvt_pk_bf16_f32 v40, v24, v25
    v_mfma_f32_32x32x16_bf16 v[128:143], a[88:91], v[32:35], v[128:143]
    v_exp_f32 v24, v68
    ds_read_b128 a[60:63], v9 offset:24576
    v_add_f32 v22, v22, v26
    v_add_f32 v22, v22, v27
    buffer_load_dwordx4 v18, s[20:23], s37 offen offset:1024  lds
    v_exp_f32 v25, v69
    v_mfma_f32_32x32x16_bf16 v[80:95], a[68:71], v[36:39], v[80:95]
    v_cvt_pk_bf16_f32 v41, v26, v27
    v_exp_f32 v26, v70
    v_add_f32 v22, v22, v24
    v_add_f32 v22, v22, v25
    buffer_load_dwordx4 v18, s[20:23], s37 offen offset:2048  lds
    v_exp_f32 v27, v71
    v_mfma_f32_32x32x16_bf16 v[96:111], a[76:79], v[36:39], v[96:111]
    v_cvt_pk_bf16_f32 v42, v24, v25
    v_exp_f32 v24, v72
    v_add_f32 v22, v22, v26
    v_add_f32 v22, v22, v27
    buffer_load_dwordx4 v18, s[20:23], s37 offen offset:3072  lds
    v_mfma_f32_32x32x16_bf16 v[112:127], a[84:87], v[36:39], v[112:127]
    v_exp_f32 v25, v73
    v_cvt_pk_bf16_f32 v43, v26, v27
    v_add_f32 v22, v22, v24
    v_add_f32 v22, v22, v25
    v_cvt_pk_bf16_f32 v44, v24, v25
    v_mfma_f32_32x32x16_bf16 v[128:143], a[92:95], v[36:39], v[128:143]
    s_waitcnt vmcnt(8) lgkmcnt(0)
    s_barrier
    v_mfma_f32_32x32x16_bf16 v[48:63], a[32:35], a[0:3], v[144:159]
    v_exp_f32 v26, v74
    ds_read_b64_tr_b16 a[64:65], v10 offset:0
    ds_read_b64_tr_b16 a[66:67], v10 offset:2048
    ds_read_b64_tr_b16 a[72:73], v11 offset:0
    v_exp_f32 v27, v75
    s_add_u32 m0, s45, 24576
    s_bfe_u32 s37, s52, 0x30018
    s_lshl_b32 s37, s37, 13
    buffer_load_dwordx4 v14, s[16:19], s37 offen offset:0  lds
    ds_read_b64_tr_b16 a[74:75], v11 offset:2048
    v_mfma_f32_32x32x16_bf16 v[48:63], a[36:39], a[4:7], v[48:63]
    ds_read_b64_tr_b16 a[80:81], v12 offset:0
    v_exp_f32 v24, v76
    ds_read_b64_tr_b16 a[82:83], v12 offset:2048
    ds_read_b64_tr_b16 a[88:89], v13 offset:0
    v_add_f32 v22, v22, v26
    v_mfma_f32_32x32x16_bf16 v[48:63], a[40:43], a[8:11], v[48:63]
    ds_read_b64_tr_b16 a[90:91], v13 offset:2048
    v_add_f32 v22, v22, v27
    ds_read_b64_tr_b16 a[68:69], v10 offset:4096
    v_exp_f32 v25, v77
    ds_read_b64_tr_b16 a[70:71], v10 offset:6144
    v_mfma_f32_32x32x16_bf16 v[48:63], a[44:47], a[12:15], v[48:63]
    ds_read_b64_tr_b16 a[76:77], v11 offset:4096
    v_cvt_pk_bf16_f32 v45, v26, v27
    ds_read_b64_tr_b16 a[78:79], v11 offset:6144
    v_exp_f32 v26, v78
    buffer_load_dwordx4 v15, s[16:19], s37 offen offset:1024  lds
    ds_read_b64_tr_b16 a[84:85], v12 offset:4096
    ds_read_b64_tr_b16 a[86:87], v12 offset:6144
    v_mfma_f32_32x32x16_bf16 v[48:63], a[48:51], a[16:19], v[48:63]
    v_add_f32 v22, v22, v24
    ds_read_b64_tr_b16 a[92:93], v13 offset:4096
    v_add_f32 v22, v22, v25
    ds_read_b64_tr_b16 a[94:95], v13 offset:6144
    buffer_load_dwordx4 v16, s[16:19], s37 offen offset:2048  lds
    v_exp_f32 v27, v79
    v_mfma_f32_32x32x16_bf16 v[48:63], a[52:55], a[20:23], v[48:63]
    v_cvt_pk_bf16_f32 v46, v24, v25
    v_add_f32 v22, v22, v26
    buffer_load_dwordx4 v17, s[16:19], s37 offen offset:3072  lds
    v_mfma_f32_32x32x16_bf16 v[48:63], a[56:59], a[24:27], v[48:63]
    v_add_f32 v22, v22, v27
    v_cvt_pk_bf16_f32 v47, v26, v27
    v_mfma_f32_32x32x16_bf16 v[48:63], a[60:63], a[28:31], v[48:63]
    v_cmp_lt_f32 vcc, s34, v22
    s_cbranch_vccnz L_r3
    L_b3:
    v_add_f32 v21, v21, v22
    s_waitcnt vmcnt(8) lgkmcnt(0)
    s_barrier
    v_mfma_f32_32x32x16_bf16 v[80:95], a[64:67], v[40:43], v[80:95]
    ds_read_b128 a[32:35], v2 offset:8192
    ds_read_b128 a[36:39], v3 offset:8192
    s_add_u32 m0, s45, 0
    s_bfe_u32 s37, s52, 0x30014
    s_lshl_b32 s37, s37, 13
    buffer_load_dwordx4 v18, s[20:23], s37 offen offset:0  lds
    ds_read_b128 a[40:43], v4 offset:8192
    v_mfma_f32_32x32x16_bf16 v[96:111], a[72:75], v[40:43], v[96:111]
    ds_read_b128 a[44:47], v5 offset:8192
    v_exp_f32 v24, v48
    v_exp_f32 v25, v49
    ds_read_b128 a[48:51], v6 offset:8192
    v_mfma_f32_32x32x16_bf16 v[112:127], a[80:83], v[40:43], v[112:127]
    v_exp_f32 v26, v50
    ds_read_b128 a[52:55], v7 offset:8192
    v_add_f32 v22, v24, v25
    v_exp_f32 v27, v51
    ds_read_b128 a[56:59], v8 offset:8192
    v_cvt_pk_bf16_f32 v32, v24, v25
    v_mfma_f32_32x32x16_bf16 v[128:143], a[88:91], v[40:43], v[128:143]
    v_exp_f32 v24, v52
    ds_read_b128 a[60:63], v9 offset:8192
    v_add_f32 v22, v22, v26
    v_add_f32 v22, v22, v27
    buffer_load_dwordx4 v18, s[20:23], s37 offen offset:1024  lds
    v_exp_f32 v25, v53
    v_mfma_f32_32x32x16_bf16 v[80:95], a[68:71], v[44:47], v[80:95]
    v_cvt_pk_bf16_f32 v33, v26, v27
    v_exp_f32 v26, v54
    v_add_f32 v22, v22, v24
    v_add_f32 v22, v22, v25
    buffer_load_dwordx4 v18, s[20:23], s37 offen offset:2048  lds
    v_exp_f32 v27, v55
    v_mfma_f32_32x32x16_bf16 v[96:111], a[76:79], v[44:47], v[96:111]
    v_cvt_pk_bf16_f32 v34, v24, v25
    v_exp_f32 v24, v56
    v_add_f32 v22, v22, v26
    v_add_f32 v22, v22, v27
    buffer_load_dwordx4 v18, s[20:23], s37 offen offset:3072  lds
    v_mfma_f32_32x32x16_bf16 v[112:127], a[84:87], v[44:47], v[112:127]
    v_exp_f32 v25, v57
    v_cvt_pk_bf16_f32 v35, v26, v27
    v_add_f32 v22, v22, v24
    v_add_f32 v22, v22, v25
    v_cvt_pk_bf16_f32 v36, v24, v25
    v_mfma_f32_32x32x16_bf16 v[128:143], a[92:95], v[44:47], v[128:143]
    s_waitcnt vmcnt(8) lgkmcnt(0)
    s_barrier
    v_mfma_f32_32x32x16_bf16 v[64:79], a[32:35], a[0:3], v[144:159]
    v_exp_f32 v26, v58
    ds_read_b64_tr_b16 a[64:65], v10 offset:16384
    ds_read_b64_tr_b16 a[66:67], v10 offset:18432
    ds_read_b64_tr_b16 a[72:73], v11 offset:16384
    v_exp_f32 v27, v59
    s_add_u32 m0, s45, 8192
    s_bfe_u32 s37, s52, 0x3001c
    s_lshl_b32 s37, s37, 13
    buffer_load_dwordx4 v14, s[16:19], s37 offen offset:0  lds
    ds_read_b64_tr_b16 a[74:75], v11 offset:18432
    v_mfma_f32_32x32x16_bf16 v[64:79], a[36:39], a[4:7], v[64:79]
    ds_read_b64_tr_b16 a[80:81], v12 offset:16384
    v_exp_f32 v24, v60
    ds_read_b64_tr_b16 a[82:83], v12 offset:18432
    ds_read_b64_tr_b16 a[88:89], v13 offset:16384
    v_add_f32 v22, v22, v26
    v_mfma_f32_32x32x16_bf16 v[64:79], a[40:43], a[8:11], v[64:79]
    ds_read_b64_tr_b16 a[90:91], v13 offset:18432
    v_add_f32 v22, v22, v27
    ds_read_b64_tr_b16 a[68:69], v10 offset:20480
    v_exp_f32 v25, v61
    ds_read_b64_tr_b16 a[70:71], v10 offset:22528
    v_mfma_f32_32x32x16_bf16 v[64:79], a[44:47], a[12:15], v[64:79]
    ds_read_b64_tr_b16 a[76:77], v11 offset:20480
    v_cvt_pk_bf16_f32 v37, v26, v27
    ds_read_b64_tr_b16 a[78:79], v11 offset:22528
    v_exp_f32 v26, v62
    buffer_load_dwordx4 v15, s[16:19], s37 offen offset:1024  lds
    ds_read_b64_tr_b16 a[84:85], v12 offset:20480
    ds_read_b64_tr_b16 a[86:87], v12 offset:22528
    v_mfma_f32_32x32x16_bf16 v[64:79], a[48:51], a[16:19], v[64:79]
    v_add_f32 v22, v22, v24
    ds_read_b64_tr_b16 a[92:93], v13 offset:20480
    v_add_f32 v22, v22, v25
    ds_read_b64_tr_b16 a[94:95], v13 offset:22528
    buffer_load_dwordx4 v16, s[16:19], s37 offen offset:2048  lds
    v_exp_f32 v27, v63
    v_mfma_f32_32x32x16_bf16 v[64:79], a[52:55], a[20:23], v[64:79]
    v_cvt_pk_bf16_f32 v38, v24, v25
    v_add_f32 v22, v22, v26
    buffer_load_dwordx4 v17, s[16:19], s37 offen offset:3072  lds
    v_mfma_f32_32x32x16_bf16 v[64:79], a[56:59], a[24:27], v[64:79]
    v_add_f32 v22, v22, v27
    v_cvt_pk_bf16_f32 v39, v26, v27
    v_mfma_f32_32x32x16_bf16 v[64:79], a[60:63], a[28:31], v[64:79]
    v_cmp_lt_f32 vcc, s34, v22
    s_cbranch_vccnz L_r4
    L_b4:
    v_add_f32 v21, v21, v22
    s_waitcnt vmcnt(8) lgkmcnt(0)
    s_barrier
    v_mfma_f32_32x32x16_bf16 v[80:95], a[64:67], v[32:35], v[80:95]
    ds_read_b128 a[32:35], v2 offset:24576
    ds_read_b128 a[36:39], v3 offset:24576
    s_add_u32 m0, s45, 16384
    s_bfe_u32 s37, s52, 0x30018
    s_lshl_b32 s37, s37, 13
    buffer_load_dwordx4 v18, s[20:23], s37 offen offset:0  lds
    ds_read_b128 a[40:43], v4 offset:24576
    v_mfma_f32_32x32x16_bf16 v[96:111], a[72:75], v[32:35], v[96:111]
    ds_read_b128 a[44:47], v5 offset:24576
    v_exp_f32 v24, v64
    v_exp_f32 v25, v65
    ds_read_b128 a[48:51], v6 offset:24576
    v_mfma_f32_32x32x16_bf16 v[112:127], a[80:83], v[32:35], v[112:127]
    v_exp_f32 v26, v66
    ds_read_b128 a[52:55], v7 offset:24576
    v_add_f32 v22, v24, v25
    v_exp_f32 v27, v67
    ds_read_b128 a[56:59], v8 offset:24576
    v_cvt_pk_bf16_f32 v40, v24, v25
    v_mfma_f32_32x32x16_bf16 v[128:143], a[88:91], v[32:35], v[128:143]
    v_exp_f32 v24, v68
    ds_read_b128 a[60:63], v9 offset:24576
    v_add_f32 v22, v22, v26
    v_add_f32 v22, v22, v27
    buffer_load_dwordx4 v18, s[20:23], s37 offen offset:1024  lds
    v_exp_f32 v25, v69
    v_mfma_f32_32x32x16_bf16 v[80:95], a[68:71], v[36:39], v[80:95]
    v_cvt_pk_bf16_f32 v41, v26, v27
    v_exp_f32 v26, v70
    v_add_f32 v22, v22, v24
    v_add_f32 v22, v22, v25
    buffer_load_dwordx4 v18, s[20:23], s37 offen offset:2048  lds
    v_exp_f32 v27, v71
    v_mfma_f32_32x32x16_bf16 v[96:111], a[76:79], v[36:39], v[96:111]
    v_cvt_pk_bf16_f32 v42, v24, v25
    v_exp_f32 v24, v72
    v_add_f32 v22, v22, v26
    v_add_f32 v22, v22, v27
    buffer_load_dwordx4 v18, s[20:23], s37 offen offset:3072  lds
    v_mfma_f32_32x32x16_bf16 v[112:127], a[84:87], v[36:39], v[112:127]
    v_exp_f32 v25, v73
    v_cvt_pk_bf16_f32 v43, v26, v27
    v_add_f32 v22, v22, v24
    v_add_f32 v22, v22, v25
    v_cvt_pk_bf16_f32 v44, v24, v25
    v_mfma_f32_32x32x16_bf16 v[128:143], a[92:95], v[36:39], v[128:143]
    s_waitcnt vmcnt(8) lgkmcnt(0)
    s_barrier
    v_mfma_f32_32x32x16_bf16 v[48:63], a[32:35], a[0:3], v[144:159]
    v_exp_f32 v26, v74
    ds_read_b64_tr_b16 a[64:65], v10 offset:0
    ds_read_b64_tr_b16 a[66:67], v10 offset:2048
    ds_read_b64_tr_b16 a[72:73], v11 offset:0
    v_exp_f32 v27, v75
    ds_read_b64_tr_b16 a[74:75], v11 offset:2048
    v_mfma_f32_32x32x16_bf16 v[48:63], a[36:39], a[4:7], v[48:63]
    ds_read_b64_tr_b16 a[80:81], v12 offset:0
    v_exp_f32 v24, v76
    ds_read_b64_tr_b16 a[82:83], v12 offset:2048
    ds_read_b64_tr_b16 a[88:89], v13 offset:0
    v_add_f32 v22, v22, v26
    v_mfma_f32_32x32x16_bf16 v[48:63], a[40:43], a[8:11], v[48:63]
    ds_read_b64_tr_b16 a[90:91], v13 offset:2048
    v_add_f32 v22, v22, v27
    ds_read_b64_tr_b16 a[68:69], v10 offset:4096
    v_exp_f32 v25, v77
    ds_read_b64_tr_b16 a[70:71], v10 offset:6144
    v_mfma_f32_32x32x16_bf16 v[48:63], a[44:47], a[12:15], v[48:63]
    ds_read_b64_tr_b16 a[76:77], v11 offset:4096
    v_cvt_pk_bf16_f32 v45, v26, v27
    ds_read_b64_tr_b16 a[78:79], v11 offset:6144
    v_exp_f32 v26, v78
    ds_read_b64_tr_b16 a[84:85], v12 offset:4096
    ds_read_b64_tr_b16 a[86:87], v12 offset:6144
    v_mfma_f32_32x32x16_bf16 v[48:63], a[48:51], a[16:19], v[48:63]
    v_add_f32 v22, v22, v24
    ds_read_b64_tr_b16 a[92:93], v13 offset:4096
    v_add_f32 v22, v22, v25
    ds_read_b64_tr_b16 a[94:95], v13 offset:6144
    v_exp_f32 v27, v79
    v_mfma_f32_32x32x16_bf16 v[48:63], a[52:55], a[20:23], v[48:63]
    v_cvt_pk_bf16_f32 v46, v24, v25
    v_add_f32 v22, v22, v26
    v_mfma_f32_32x32x16_bf16 v[48:63], a[56:59], a[24:27], v[48:63]
    v_add_f32 v22, v22, v27
    v_cvt_pk_bf16_f32 v47, v26, v27
    v_mfma_f32_32x32x16_bf16 v[48:63], a[60:63], a[28:31], v[48:63]
    v_cmp_lt_f32 vcc, s34, v22
    s_cbranch_vccnz L_r5
    L_b5:
    v_add_f32 v21, v21, v22
    s_waitcnt vmcnt(4) lgkmcnt(0)
    s_barrier
    v_mfma_f32_32x32x16_bf16 v[80:95], a[64:67], v[40:43], v[80:95]
    ds_read_b128 a[32:35], v2 offset:8192
    ds_read_b128 a[36:39], v3 offset:8192
    s_add_u32 m0, s45, 0
    s_bfe_u32 s37, s52, 0x3001c
    s_lshl_b32 s37, s37, 13
    buffer_load_dwordx4 v18, s[20:23], s37 offen offset:0  lds
    ds_read_b128 a[40:43], v4 offset:8192
    v_mfma_f32_32x32x16_bf16 v[96:111], a[72:75], v[40:43], v[96:111]
    ds_read_b128 a[44:47], v5 offset:8192
    v_exp_f32 v24, v48
    v_exp_f32 v25, v49
    ds_read_b128 a[48:51], v6 offset:8192
    v_mfma_f32_32x32x16_bf16 v[112:127], a[80:83], v[40:43], v[112:127]
    v_exp_f32 v26, v50
    ds_read_b128 a[52:55], v7 offset:8192
    v_add_f32 v22, v24, v25
    v_exp_f32 v27, v51
    ds_read_b128 a[56:59], v8 offset:8192
    v_cvt_pk_bf16_f32 v32, v24, v25
    v_mfma_f32_32x32x16_bf16 v[128:143], a[88:91], v[40:43], v[128:143]
    v_exp_f32 v24, v52
    ds_read_b128 a[60:63], v9 offset:8192
    v_add_f32 v22, v22, v26
    v_add_f32 v22, v22, v27
    buffer_load_dwordx4 v18, s[20:23], s37 offen offset:1024  lds
    v_exp_f32 v25, v53
    v_mfma_f32_32x32x16_bf16 v[80:95], a[68:71], v[44:47], v[80:95]
    v_cvt_pk_bf16_f32 v33, v26, v27
    v_exp_f32 v26, v54
    v_add_f32 v22, v22, v24
    v_add_f32 v22, v22, v25
    buffer_load_dwordx4 v18, s[20:23], s37 offen offset:2048  lds
    v_exp_f32 v27, v55
    v_mfma_f32_32x32x16_bf16 v[96:111], a[76:79], v[44:47], v[96:111]
    v_cvt_pk_bf16_f32 v34, v24, v25
    v_exp_f32 v24, v56
    v_add_f32 v22, v22, v26
    v_add_f32 v22, v22, v27
    buffer_load_dwordx4 v18, s[20:23], s37 offen offset:3072  lds
    v_mfma_f32_32x32x16_bf16 v[112:127], a[84:87], v[44:47], v[112:127]
    v_exp_f32 v25, v57
    v_cvt_pk_bf16_f32 v35, v26, v27
    v_add_f32 v22, v22, v24
    v_add_f32 v22, v22, v25
    v_cvt_pk_bf16_f32 v36, v24, v25
    v_mfma_f32_32x32x16_bf16 v[128:143], a[92:95], v[44:47], v[128:143]
    s_waitcnt vmcnt(4) lgkmcnt(0)
    s_barrier
    v_mfma_f32_32x32x16_bf16 v[64:79], a[32:35], a[0:3], v[144:159]
    v_exp_f32 v26, v58
    ds_read_b64_tr_b16 a[64:65], v10 offset:16384
    ds_read_b64_tr_b16 a[66:67], v10 offset:18432
    ds_read_b64_tr_b16 a[72:73], v11 offset:16384
    v_exp_f32 v27, v59
    ds_read_b64_tr_b16 a[74:75], v11 offset:18432
    v_mfma_f32_32x32x16_bf16 v[64:79], a[36:39], a[4:7], v[64:79]
    ds_read_b64_tr_b16 a[80:81], v12 offset:16384
    v_exp_f32 v24, v60
    ds_read_b64_tr_b16 a[82:83], v12 offset:18432
    ds_read_b64_tr_b16 a[88:89], v13 offset:16384
    v_add_f32 v22, v22, v26
    v_mfma_f32_32x32x16_bf16 v[64:79], a[40:43], a[8:11], v[64:79]
    v_lshlrev_b32 v31, 4, v0
    s_mul_i32 s39, s47, 12288
    s_add_u32 s39, s39, s32
    ds_read_b64_tr_b16 a[90:91], v13 offset:18432
    v_add_f32 v22, v22, v27
    ds_read_b64_tr_b16 a[68:69], v10 offset:20480
    v_exp_f32 v25, v61
    v_lshlrev_b32 v30, 3, v0
    s_lshl_b32 s40, s47, 9
    s_add_u32 s40, s40, s32
    ds_read_b64_tr_b16 a[70:71], v10 offset:22528
    v_mfma_f32_32x32x16_bf16 v[64:79], a[44:47], a[12:15], v[64:79]
    ds_read_b64_tr_b16 a[76:77], v11 offset:20480
    v_cvt_pk_bf16_f32 v37, v26, v27
    v_add_u32 v31, s39, v31
    ds_read_b64_tr_b16 a[78:79], v11 offset:22528
    v_exp_f32 v26, v62
    v_add_u32 v30, s40, v30
    ds_read_b64_tr_b16 a[84:85], v12 offset:20480
    s_xor_b32 s41, s46, 1
    s_sub_i32 s41, s41, s46
    s_mul_i32 s41, s41, 36864
    v_add_u32 v3, s41, v30
    ds_read_b64_tr_b16 a[86:87], v12 offset:22528
    v_mfma_f32_32x32x16_bf16 v[64:79], a[48:51], a[16:19], v[64:79]
    v_add_f32 v22, v22, v24
    ds_read_b64_tr_b16 a[92:93], v13 offset:20480
    v_add_f32 v22, v22, v25
    v_add_u32 v7, s41, v31
    ds_read_b64_tr_b16 a[94:95], v13 offset:22528
    v_exp_f32 v27, v63
    s_xor_b32 s41, s46, 2
    s_sub_i32 s41, s41, s46
    s_mul_i32 s41, s41, 36864
    v_add_u32 v4, s41, v30
    v_mfma_f32_32x32x16_bf16 v[64:79], a[52:55], a[20:23], v[64:79]
    v_cvt_pk_bf16_f32 v38, v24, v25
    v_add_u32 v8, s41, v31
    v_add_f32 v22, v22, v26
    s_xor_b32 s41, s46, 3
    s_sub_i32 s41, s41, s46
    s_mul_i32 s41, s41, 36864
    v_add_u32 v5, s41, v30
    v_mfma_f32_32x32x16_bf16 v[64:79], a[56:59], a[24:27], v[64:79]
    v_add_f32 v22, v22, v27
    v_cvt_pk_bf16_f32 v39, v26, v27
    v_add_u32 v9, s41, v31
    v_lshl_add_u32 v6, v0, 4, s32
    v_mfma_f32_32x32x16_bf16 v[64:79], a[60:63], a[28:31], v[64:79]
    v_cmp_lt_f32 vcc, s34, v22
    s_cbranch_vccnz L_r6
    L_b6:
    v_add_f32 v21, v21, v22
    s_waitcnt vmcnt(0) lgkmcnt(0)
    s_barrier
    v_mfma_f32_32x32x16_bf16 v[80:95], a[64:67], v[32:35], v[80:95]
    ds_read_b64_tr_b16 a[32:33], v10 offset:0
    ds_read_b64_tr_b16 a[34:35], v10 offset:2048
    ds_read_b64_tr_b16 a[36:37], v10 offset:4096
    ds_read_b64_tr_b16 a[38:39], v10 offset:6144
    v_mfma_f32_32x32x16_bf16 v[96:111], a[72:75], v[32:35], v[96:111]
    s_nop 0
    v_exp_f32 v24, v64
    ds_read_b64_tr_b16 a[40:41], v11 offset:0
    v_exp_f32 v25, v65
    v_exp_f32 v26, v66
    ds_read_b64_tr_b16 a[42:43], v11 offset:2048
    v_add_f32 v22, v24, v25
    ds_read_b64_tr_b16 a[44:45], v11 offset:4096
    v_exp_f32 v27, v67
    v_mfma_f32_32x32x16_bf16 v[112:127], a[80:83], v[32:35], v[112:127]
    v_cvt_pk_bf16_f32 v40, v24, v25
    ds_read_b64_tr_b16 a[46:47], v11 offset:6144
    v_exp_f32 v24, v68
    v_add_f32 v22, v22, v26
    ds_read_b64_tr_b16 a[48:49], v12 offset:0
    v_add_f32 v22, v22, v27
    v_exp_f32 v25, v69
    ds_read_b64_tr_b16 a[50:51], v12 offset:2048
    v_cvt_pk_bf16_f32 v41, v26, v27
    v_exp_f32 v26, v70
    v_mfma_f32_32x32x16_bf16 v[128:143], a[88:91], v[32:35], v[128:143]
    ds_read_b64_tr_b16 a[52:53], v12 offset:4096
    v_add_f32 v22, v22, v24
    v_add_f32 v22, v22, v25
    v_exp_f32 v27, v71
    ds_read_b64_tr_b16 a[54:55], v12 offset:6144
    v_cvt_pk_bf16_f32 v42, v24, v25
    v_exp_f32 v24, v72
    ds_read_b64_tr_b16 a[56:57], v13 offset:0
    v_add_f32 v22, v22, v26
    v_mfma_f32_32x32x16_bf16 v[80:95], a[68:71], v[36:39], v[80:95]
    v_add_f32 v22, v22, v27
    ds_read_b64_tr_b16 a[58:59], v13 offset:2048
    v_exp_f32 v25, v73
    v_cvt_pk_bf16_f32 v43, v26, v27
    ds_read_b64_tr_b16 a[60:61], v13 offset:4096
    v_exp_f32 v26, v74
    v_add_f32 v22, v22, v24
    ds_read_b64_tr_b16 a[62:63], v13 offset:6144
    v_add_f32 v22, v22, v25
    v_exp_f32 v27, v75
    ds_read_b128 a[0:3], v6 offset:34816
    v_mfma_f32_32x32x16_bf16 v[96:111], a[76:79], v[36:39], v[96:111]
    v_cvt_pk_bf16_f32 v44, v24, v25
    v_exp_f32 v24, v76
    ds_read_b128 a[4:7], v6 offset:35840
    v_add_f32 v22, v22, v26
    v_add_f32 v22, v22, v27
    v_exp_f32 v25, v77
    v_cvt_pk_bf16_f32 v45, v26, v27
    v_exp_f32 v26, v78
    v_mfma_f32_32x32x16_bf16 v[112:127], a[84:87], v[36:39], v[112:127]
    v_add_f32 v22, v22, v24
    v_add_f32 v22, v22, v25
    v_exp_f32 v27, v79
    v_cvt_pk_bf16_f32 v46, v24, v25
    v_add_f32 v22, v22, v26
    v_add_f32 v22, v22, v27
    v_cvt_pk_bf16_f32 v47, v26, v27
    v_mfma_f32_32x32x16_bf16 v[128:143], a[92:95], v[36:39], v[128:143]
    v_cmp_lt_f32 vcc, s34, v22
    s_cbranch_vccnz L_r7
    L_b7:
    v_add_f32 v21, v21, v22
    s_waitcnt lgkmcnt(0)
    v_mfma_f32_32x32x16_bf16 v[96:111], a[40:43], v[40:43], v[96:111]
    v_mov_b32 v24, v21
    v_mov_b32 v20, v144
    s_lshl_b32 s40, s47, 13
    s_lshl_b32 s44, s46, 6
    v_mfma_f32_32x32x16_bf16 v[96:111], a[44:47], v[44:47], v[96:111]
    v_permlane32_swap_b32 v24, v21
    v_and_b32 v25, 31, v0
    v_add_f32 v21, v21, v24
    s_add_u32 s40, s40, s44
    v_mfma_f32_32x32x16_bf16 v[112:127], a[48:51], v[40:43], v[112:127]
    ds_write_b64 v30, v[20:21] offset:32768
    v_lshlrev_b32 v25, 8, v25
    v_lshrrev_b32 v26, 5, v0
    v_lshl_add_u32 v2, v26, 4, v25
    v_and_b32 v2, 0xf1f, v2
    v_and_b32 v25, 16, v0
    v_lshl_add_u32 v2, v25, 1, v2
    s_add_u32 s41, s40, 4096
    v_mfma_f32_32x32x16_bf16 v[112:127], a[52:55], v[44:47], v[112:127]
    v_cvt_pk_bf16_f32 v48, v96, v97
    v_cvt_pk_bf16_f32 v49, v98, v99
    v_cvt_pk_bf16_f32 v50, v100, v101
    v_cvt_pk_bf16_f32 v51, v102, v103
    ds_write_b128 v31, v[48:51] offset:8192
    v_mfma_f32_32x32x16_bf16 v[128:143], a[56:59], v[40:43], v[128:143]
    v_cvt_pk_bf16_f32 v52, v104, v105
    v_cvt_pk_bf16_f32 v53, v106, v107
    v_cvt_pk_bf16_f32 v54, v108, v109
    v_cvt_pk_bf16_f32 v55, v110, v111
    ds_write_b128 v31, v[52:55] offset:9216
    v_mfma_f32_32x32x16_bf16 v[128:143], a[60:63], v[44:47], v[128:143]
    v_cvt_pk_bf16_f32 v56, v112, v113
    v_cvt_pk_bf16_f32 v57, v114, v115
    v_cvt_pk_bf16_f32 v58, v116, v117
    v_cvt_pk_bf16_f32 v59, v118, v119
    ds_write_b128 v31, v[56:59] offset:12288
    v_cvt_pk_bf16_f32 v60, v120, v121
    v_cvt_pk_bf16_f32 v61, v122, v123
    v_cvt_pk_bf16_f32 v62, v124, v125
    v_cvt_pk_bf16_f32 v63, v126, v127
    ds_write_b128 v31, v[60:63] offset:13312
    s_nop 1
    v_cvt_pk_bf16_f32 v64, v128, v129
    v_cvt_pk_bf16_f32 v65, v130, v131
    v_cvt_pk_bf16_f32 v66, v132, v133
    v_cvt_pk_bf16_f32 v67, v134, v135
    ds_write_b128 v31, v[64:67] offset:16384
    v_cvt_pk_bf16_f32 v68, v136, v137
    v_cvt_pk_bf16_f32 v69, v138, v139
    v_cvt_pk_bf16_f32 v70, v140, v141
    v_cvt_pk_bf16_f32 v71, v142, v143
    ds_write_b128 v31, v[68:71] offset:17408
    v_mfma_f32_32x32x16_bf16 v[80:95], a[32:35], v[40:43], v[80:95]
    v_mfma_f32_32x32x16_bf16 v[80:95], a[36:39], v[44:47], v[80:95]
    s_waitcnt lgkmcnt(0)
    s_barrier
    ds_read_b64 v[12:13], v3 offset:32768
    ds_read_b64 v[14:15], v4 offset:32768
    ds_read_b64 v[16:17], v5 offset:32768
    ds_read_b128 v[96:99], v7 offset:8192
    ds_read_b128 v[100:103], v7 offset:9216
    ds_read_b128 v[112:115], v8 offset:12288
    ds_read_b128 v[116:119], v8 offset:13312
    ds_read_b128 v[128:131], v9 offset:16384
    ds_read_b128 v[132:135], v9 offset:17408
    s_waitcnt lgkmcnt(6)
    v_min3_f32 v3, v12, v14, v16
    v_max3_f32 v4, v12, v14, v16
    v_min_f32 v3, v3, v20
    v_max_f32 v4, v4, v20
    v_add_f32 v10, v21, v13
    v_cmp_lg_f32 vcc, v3, v4
    v_add_f32 v11, v15, v17
    s_cbranch_vccnz L_slowc
    s_waitcnt lgkmcnt(5)
    v_mfma_f32_32x32x16_bf16 v[80:95], a[0:3], v[96:99], v[80:95]
    v_add_f32 v10, v10, v11
    s_waitcnt lgkmcnt(4)
    v_mfma_f32_32x32x16_bf16 v[80:95], a[4:7], v[100:103], v[80:95]
    v_rcp_f32 v10, v10
    s_waitcnt lgkmcnt(3)
    v_mfma_f32_32x32x16_bf16 v[80:95], a[0:3], v[112:115], v[80:95]
    s_waitcnt lgkmcnt(2)
    v_mfma_f32_32x32x16_bf16 v[80:95], a[4:7], v[116:119], v[80:95]
    s_waitcnt lgkmcnt(1)
    v_lshlrev_b32 v64, 16, v128
    v_and_b32 v65, s35, v128
    v_lshlrev_b32 v66, 16, v129
    v_and_b32 v67, s35, v129
    v_lshlrev_b32 v68, 16, v130
    v_and_b32 v69, s35, v130
    v_lshlrev_b32 v70, 16, v131
    v_and_b32 v71, s35, v131
    s_waitcnt lgkmcnt(0)
    v_lshlrev_b32 v72, 16, v132
    v_and_b32 v73, s35, v132
    v_lshlrev_b32 v74, 16, v133
    v_and_b32 v75, s35, v133
    v_lshlrev_b32 v76, 16, v134
    v_and_b32 v77, s35, v134
    v_lshlrev_b32 v78, 16, v135
    v_and_b32 v79, s35, v135
    v_pk_mul_f32 v[64:65], v[64:65], v[10:11] op_sel_hi:[1,0]
    v_pk_mul_f32 v[66:67], v[66:67], v[10:11] op_sel_hi:[1,0]
    v_pk_mul_f32 v[68:69], v[68:69], v[10:11] op_sel_hi:[1,0]
    v_pk_mul_f32 v[70:71], v[70:71], v[10:11] op_sel_hi:[1,0]
    v_pk_mul_f32 v[72:73], v[72:73], v[10:11] op_sel_hi:[1,0]
    v_pk_mul_f32 v[74:75], v[74:75], v[10:11] op_sel_hi:[1,0]
    v_pk_mul_f32 v[76:77], v[76:77], v[10:11] op_sel_hi:[1,0]
    v_pk_mul_f32 v[78:79], v[78:79], v[10:11] op_sel_hi:[1,0]
    v_pk_fma_f32 v[80:81], v[80:81], v[10:11], v[64:65] op_sel_hi:[1,0,1]
    v_pk_fma_f32 v[82:83], v[82:83], v[10:11], v[66:67] op_sel_hi:[1,0,1]
    v_pk_fma_f32 v[84:85], v[84:85], v[10:11], v[68:69] op_sel_hi:[1,0,1]
    v_pk_fma_f32 v[86:87], v[86:87], v[10:11], v[70:71] op_sel_hi:[1,0,1]
    v_pk_fma_f32 v[88:89], v[88:89], v[10:11], v[72:73] op_sel_hi:[1,0,1]
    v_pk_fma_f32 v[90:91], v[90:91], v[10:11], v[74:75] op_sel_hi:[1,0,1]
    v_pk_fma_f32 v[92:93], v[92:93], v[10:11], v[76:77] op_sel_hi:[1,0,1]
    v_pk_fma_f32 v[94:95], v[94:95], v[10:11], v[78:79] op_sel_hi:[1,0,1]
L_fin:
    v_cvt_pk_bf16_f32 v24, v80, v81
    v_cvt_pk_bf16_f32 v25, v82, v83
    v_cvt_pk_bf16_f32 v26, v84, v85
    v_cvt_pk_bf16_f32 v27, v86, v87
    v_cvt_pk_bf16_f32 v28, v88, v89
    v_cvt_pk_bf16_f32 v29, v90, v91
    v_cvt_pk_bf16_f32 v30, v92, v93
    v_cvt_pk_bf16_f32 v31, v94, v95
    v_permlane16_swap_b32 v24, v28
    v_permlane16_swap_b32 v25, v29
    v_permlane16_swap_b32 v26, v30
    v_permlane16_swap_b32 v27, v31
    buffer_store_dwordx4 v[24:27], v2, s[28:31], s40 offen sc1
    buffer_store_dwordx4 v[28:31], v2, s[28:31], s41 offen sc1
L_end:
    s_endpgm
L_slowc:
    s_nop 7
    v_min3_f32 v3, v12, v14, v16
    v_min_f32 v3, v3, v20
    v_sub_f32 v10, v3, v20
    v_sub_f32 v12, v3, v12
    v_sub_f32 v14, v3, v14
    v_sub_f32 v16, v3, v16
    v_exp_f32 v10, v10
    v_exp_f32 v12, v12
    v_exp_f32 v14, v14
    v_exp_f32 v16, v16
    v_mul_f32 v3, v10, v21
    v_fmac_f32 v3, v12, v13
    v_fmac_f32 v3, v14, v15
    v_fmac_f32 v3, v16, v17
    v_rcp_f32 v3, v3
    s_waitcnt lgkmcnt(4)
    v_lshlrev_b32 v32, 16, v96
    v_and_b32 v33, s35, v96
    v_lshlrev_b32 v34, 16, v97
    v_and_b32 v35, s35, v97
    v_lshlrev_b32 v36, 16, v98
    v_and_b32 v37, s35, v98
    v_lshlrev_b32 v38, 16, v99
    v_and_b32 v39, s35, v99
    v_lshlrev_b32 v40, 16, v100
    v_and_b32 v41, s35, v100
    v_lshlrev_b32 v42, 16, v101
    v_and_b32 v43, s35, v101
    v_lshlrev_b32 v44, 16, v102
    v_and_b32 v45, s35, v102
    v_lshlrev_b32 v46, 16, v103
    v_and_b32 v47, s35, v103
    v_mul_f32 v10, v10, v3
    v_mul_f32 v12, v12, v3
    v_mul_f32 v14, v14, v3
    v_mul_f32 v16, v16, v3
    v_pk_mul_f32 v[80:81], v[80:81], v[10:11] op_sel_hi:[1,0]
    v_pk_mul_f32 v[82:83], v[82:83], v[10:11] op_sel_hi:[1,0]
    v_pk_mul_f32 v[84:85], v[84:85], v[10:11] op_sel_hi:[1,0]
    v_pk_mul_f32 v[86:87], v[86:87], v[10:11] op_sel_hi:[1,0]
    v_pk_mul_f32 v[88:89], v[88:89], v[10:11] op_sel_hi:[1,0]
    v_pk_mul_f32 v[90:91], v[90:91], v[10:11] op_sel_hi:[1,0]
    v_pk_mul_f32 v[92:93], v[92:93], v[10:11] op_sel_hi:[1,0]
    v_pk_mul_f32 v[94:95], v[94:95], v[10:11] op_sel_hi:[1,0]
    s_waitcnt lgkmcnt(4)
    v_pk_fma_f32 v[80:81], v[32:33], v[12:13], v[80:81] op_sel_hi:[1,0,1]
    v_pk_fma_f32 v[82:83], v[34:35], v[12:13], v[82:83] op_sel_hi:[1,0,1]
    v_pk_fma_f32 v[84:85], v[36:37], v[12:13], v[84:85] op_sel_hi:[1,0,1]
    v_pk_fma_f32 v[86:87], v[38:39], v[12:13], v[86:87] op_sel_hi:[1,0,1]
    v_pk_fma_f32 v[88:89], v[40:41], v[12:13], v[88:89] op_sel_hi:[1,0,1]
    v_pk_fma_f32 v[90:91], v[42:43], v[12:13], v[90:91] op_sel_hi:[1,0,1]
    v_pk_fma_f32 v[92:93], v[44:45], v[12:13], v[92:93] op_sel_hi:[1,0,1]
    v_pk_fma_f32 v[94:95], v[46:47], v[12:13], v[94:95] op_sel_hi:[1,0,1]
    s_waitcnt lgkmcnt(2)
    v_lshlrev_b32 v48, 16, v112
    v_and_b32 v49, s35, v112
    v_lshlrev_b32 v50, 16, v113
    v_and_b32 v51, s35, v113
    v_lshlrev_b32 v52, 16, v114
    v_and_b32 v53, s35, v114
    v_lshlrev_b32 v54, 16, v115
    v_and_b32 v55, s35, v115
    v_lshlrev_b32 v56, 16, v116
    v_and_b32 v57, s35, v116
    v_lshlrev_b32 v58, 16, v117
    v_and_b32 v59, s35, v117
    v_lshlrev_b32 v60, 16, v118
    v_and_b32 v61, s35, v118
    v_lshlrev_b32 v62, 16, v119
    v_and_b32 v63, s35, v119
    v_pk_fma_f32 v[80:81], v[48:49], v[14:15], v[80:81] op_sel_hi:[1,0,1]
    v_pk_fma_f32 v[82:83], v[50:51], v[14:15], v[82:83] op_sel_hi:[1,0,1]
    v_pk_fma_f32 v[84:85], v[52:53], v[14:15], v[84:85] op_sel_hi:[1,0,1]
    v_pk_fma_f32 v[86:87], v[54:55], v[14:15], v[86:87] op_sel_hi:[1,0,1]
    v_pk_fma_f32 v[88:89], v[56:57], v[14:15], v[88:89] op_sel_hi:[1,0,1]
    v_pk_fma_f32 v[90:91], v[58:59], v[14:15], v[90:91] op_sel_hi:[1,0,1]
    v_pk_fma_f32 v[92:93], v[60:61], v[14:15], v[92:93] op_sel_hi:[1,0,1]
    v_pk_fma_f32 v[94:95], v[62:63], v[14:15], v[94:95] op_sel_hi:[1,0,1]
    s_waitcnt lgkmcnt(0)
    v_lshlrev_b32 v64, 16, v128
    v_and_b32 v65, s35, v128
    v_lshlrev_b32 v66, 16, v129
    v_and_b32 v67, s35, v129
    v_lshlrev_b32 v68, 16, v130
    v_and_b32 v69, s35, v130
    v_lshlrev_b32 v70, 16, v131
    v_and_b32 v71, s35, v131
    v_lshlrev_b32 v72, 16, v132
    v_and_b32 v73, s35, v132
    v_lshlrev_b32 v74, 16, v133
    v_and_b32 v75, s35, v133
    v_lshlrev_b32 v76, 16, v134
    v_and_b32 v77, s35, v134
    v_lshlrev_b32 v78, 16, v135
    v_and_b32 v79, s35, v135
    v_pk_fma_f32 v[80:81], v[64:65], v[16:17], v[80:81] op_sel_hi:[1,0,1]
    v_pk_fma_f32 v[82:83], v[66:67], v[16:17], v[82:83] op_sel_hi:[1,0,1]
    v_pk_fma_f32 v[84:85], v[68:69], v[16:17], v[84:85] op_sel_hi:[1,0,1]
    v_pk_fma_f32 v[86:87], v[70:71], v[16:17], v[86:87] op_sel_hi:[1,0,1]
    v_pk_fma_f32 v[88:89], v[72:73], v[16:17], v[88:89] op_sel_hi:[1,0,1]
    v_pk_fma_f32 v[90:91], v[74:75], v[16:17], v[90:91] op_sel_hi:[1,0,1]
    v_pk_fma_f32 v[92:93], v[76:77], v[16:17], v[92:93] op_sel_hi:[1,0,1]
    v_pk_fma_f32 v[94:95], v[78:79], v[16:17], v[94:95] op_sel_hi:[1,0,1]
    s_branch L_fin
L_r1:
    s_mov_b32 s36, 1
    s_branch L_rare1
L_r2:
    s_mov_b32 s36, 2
    s_branch L_rare0
L_r3:
    s_mov_b32 s36, 3
    s_branch L_rare1
L_r4:
    s_mov_b32 s36, 4
    s_branch L_rare0
L_r5:
    s_mov_b32 s36, 5
    s_branch L_rare1
L_r6:
    s_mov_b32 s36, 6
    s_branch L_rare0
L_r7:
    s_mov_b32 s36, 7
    s_branch L_rare1
L_rare0:
    s_nop 15
    s_nop 7
    v_max3_f32 v28, v48, v49, v50
    v_max3_f32 v29, v51, v52, v53
    v_max3_f32 v28, v28, v54, v55
    v_max3_f32 v29, v29, v56, v57
    v_max3_f32 v28, v28, v58, v59
    v_max3_f32 v29, v29, v60, v61
    v_max3_f32 v28, v28, v62, v63
    v_max_f32 v28, v28, v29
    v_mov_b32 v29, v28
    s_nop 1
    v_permlane32_swap_b32 v29, v28
    v_max3_f32 v28, v28, v29, 0
    v_exp_f32 v29, -v28
    v_sub_f32 v144, v144, v28
    v_sub_f32 v145, v145, v28
    v_sub_f32 v146, v146, v28
    v_sub_f32 v147, v147, v28
    v_sub_f32 v148, v148, v28
    v_sub_f32 v149, v149, v28
    v_sub_f32 v150, v150, v28
    v_sub_f32 v151, v151, v28
    v_sub_f32 v152, v152, v28
    v_sub_f32 v153, v153, v28
    v_sub_f32 v154, v154, v28
    v_sub_f32 v155, v155, v28
    v_sub_f32 v156, v156, v28
    v_sub_f32 v157, v157, v28
    v_sub_f32 v158, v158, v28
    v_sub_f32 v159, v159, v28
    v_sub_f32 v48, v48, v28
    v_sub_f32 v49, v49, v28
    v_sub_f32 v50, v50, v28
    v_sub_f32 v51, v51, v28
    v_sub_f32 v52, v52, v28
    v_sub_f32 v53, v53, v28
    v_sub_f32 v54, v54, v28
    v_sub_f32 v55, v55, v28
    v_sub_f32 v56, v56, v28
    v_sub_f32 v57, v57, v28
    v_sub_f32 v58, v58, v28
    v_sub_f32 v59, v59, v28
    v_sub_f32 v60, v60, v28
    v_sub_f32 v61, v61, v28
    v_sub_f32 v62, v62, v28
    v_sub_f32 v63, v63, v28
    v_sub_f32 v64, v64, v28
    v_sub_f32 v65, v65, v28
    v_sub_f32 v66, v66, v28
    v_sub_f32 v67, v67, v28
    v_sub_f32 v68, v68, v28
    v_sub_f32 v69, v69, v28
    v_sub_f32 v70, v70, v28
    v_sub_f32 v71, v71, v28
    v_sub_f32 v72, v72, v28
    v_sub_f32 v73, v73, v28
    v_sub_f32 v74, v74, v28
    v_sub_f32 v75, v75, v28
    v_sub_f32 v76, v76, v28
    v_sub_f32 v77, v77, v28
    v_sub_f32 v78, v78, v28
    v_sub_f32 v79, v79, v28
    v_mul_f32 v80, v80, v29
    v_mul_f32 v81, v81, v29
    v_mul_f32 v82, v82, v29
    v_mul_f32 v83, v83, v29
    v_mul_f32 v84, v84, v29
    v_mul_f32 v85, v85, v29
    v_mul_f32 v86, v86, v29
    v_mul_f32 v87, v87, v29
    v_mul_f32 v88, v88, v29
    v_mul_f32 v89, v89, v29
    v_mul_f32 v90, v90, v29
    v_mul_f32 v91, v91, v29
    v_mul_f32 v92, v92, v29
    v_mul_f32 v93, v93, v29
    v_mul_f32 v94, v94, v29
    v_mul_f32 v95, v95, v29
    v_mul_f32 v96, v96, v29
    v_mul_f32 v97, v97, v29
    v_mul_f32 v98, v98, v29
    v_mul_f32 v99, v99, v29
    v_mul_f32 v100, v100, v29
    v_mul_f32 v101, v101, v29
    v_mul_f32 v102, v102, v29
    v_mul_f32 v103, v103, v29
    v_mul_f32 v104, v104, v29
    v_mul_f32 v105, v105, v29
    v_mul_f32 v106, v106, v29
    v_mul_f32 v107, v107, v29
    v_mul_f32 v108, v108, v29
    v_mul_f32 v109, v109, v29
    v_mul_f32 v110, v110, v29
    v_mul_f32 v111, v111, v29
    v_mul_f32 v112, v112, v29
    v_mul_f32 v113, v113, v29
    v_mul_f32 v114, v114, v29
    v_mul_f32 v115, v115, v29
    v_mul_f32 v116, v116, v29
    v_mul_f32 v117, v117, v29
    v_mul_f32 v118, v118, v29
    v_mul_f32 v119, v119, v29
    v_mul_f32 v120, v120, v29
    v_mul_f32 v121, v121, v29
    v_mul_f32 v122, v122, v29
    v_mul_f32 v123, v123, v29
    v_mul_f32 v124, v124, v29
    v_mul_f32 v125, v125, v29
    v_mul_f32 v126, v126, v29
    v_mul_f32 v127, v127, v29
    v_mul_f32 v128, v128, v29
    v_mul_f32 v129, v129, v29
    v_mul_f32 v130, v130, v29
    v_mul_f32 v131, v131, v29
    v_mul_f32 v132, v132, v29
    v_mul_f32 v133, v133, v29
    v_mul_f32 v134, v134, v29
    v_mul_f32 v135, v135, v29
    v_mul_f32 v136, v136, v29
    v_mul_f32 v137, v137, v29
    v_mul_f32 v138, v138, v29
    v_mul_f32 v139, v139, v29
    v_mul_f32 v140, v140, v29
    v_mul_f32 v141, v141, v29
    v_mul_f32 v142, v142, v29
    v_mul_f32 v143, v143, v29
    v_mul_f32 v21, v21, v29
    v_exp_f32 v24, v48
    v_exp_f32 v25, v49
    v_exp_f32 v26, v50
    v_add_f32 v22, v24, v25
    v_exp_f32 v27, v51
    v_cvt_pk_bf16_f32 v32, v24, v25
    v_exp_f32 v24, v52
    v_add_f32 v22, v22, v26
    v_add_f32 v22, v22, v27
    v_exp_f32 v25, v53
    v_cvt_pk_bf16_f32 v33, v26, v27
    v_exp_f32 v26, v54
    v_add_f32 v22, v22, v24
    v_add_f32 v22, v22, v25
    v_exp_f32 v27, v55
    v_cvt_pk_bf16_f32 v34, v24, v25
    v_exp_f32 v24, v56
    v_add_f32 v22, v22, v26
    v_add_f32 v22, v22, v27
    v_exp_f32 v25, v57
    v_cvt_pk_bf16_f32 v35, v26, v27
    v_exp_f32 v26, v58
    v_add_f32 v22, v22, v24
    v_add_f32 v22, v22, v25
    v_exp_f32 v27, v59
    v_cvt_pk_bf16_f32 v36, v24, v25
    v_exp_f32 v24, v60
    v_add_f32 v22, v22, v26
    v_add_f32 v22, v22, v27
    v_exp_f32 v25, v61
    v_cvt_pk_bf16_f32 v37, v26, v27
    v_exp_f32 v26, v62
    v_add_f32 v22, v22, v24
    v_add_f32 v22, v22, v25
    v_exp_f32 v27, v63
    v_cvt_pk_bf16_f32 v38, v24, v25
    v_add_f32 v22, v22, v26
    v_add_f32 v22, v22, v27
    v_cvt_pk_bf16_f32 v39, v26, v27
    s_nop 1
    s_cmp_eq_u32 s36, 2
    s_cbranch_scc1 L_b2
    s_cmp_eq_u32 s36, 4
    s_cbranch_scc1 L_b4
    s_cmp_eq_u32 s36, 6
    s_cbranch_scc1 L_b6
    s_endpgm
L_rare1:
    s_nop 15
    s_nop 7
    v_max3_f32 v28, v64, v65, v66
    v_max3_f32 v29, v67, v68, v69
    v_max3_f32 v28, v28, v70, v71
    v_max3_f32 v29, v29, v72, v73
    v_max3_f32 v28, v28, v74, v75
    v_max3_f32 v29, v29, v76, v77
    v_max3_f32 v28, v28, v78, v79
    v_max_f32 v28, v28, v29
    v_mov_b32 v29, v28
    s_nop 1
    v_permlane32_swap_b32 v29, v28
    v_max3_f32 v28, v28, v29, 0
    v_exp_f32 v29, -v28
    v_sub_f32 v144, v144, v28
    v_sub_f32 v145, v145, v28
    v_sub_f32 v146, v146, v28
    v_sub_f32 v147, v147, v28
    v_sub_f32 v148, v148, v28
    v_sub_f32 v149, v149, v28
    v_sub_f32 v150, v150, v28
    v_sub_f32 v151, v151, v28
    v_sub_f32 v152, v152, v28
    v_sub_f32 v153, v153, v28
    v_sub_f32 v154, v154, v28
    v_sub_f32 v155, v155, v28
    v_sub_f32 v156, v156, v28
    v_sub_f32 v157, v157, v28
    v_sub_f32 v158, v158, v28
    v_sub_f32 v159, v159, v28
    v_sub_f32 v48, v48, v28
    v_sub_f32 v49, v49, v28
    v_sub_f32 v50, v50, v28
    v_sub_f32 v51, v51, v28
    v_sub_f32 v52, v52, v28
    v_sub_f32 v53, v53, v28
    v_sub_f32 v54, v54, v28
    v_sub_f32 v55, v55, v28
    v_sub_f32 v56, v56, v28
    v_sub_f32 v57, v57, v28
    v_sub_f32 v58, v58, v28
    v_sub_f32 v59, v59, v28
    v_sub_f32 v60, v60, v28
    v_sub_f32 v61, v61, v28
    v_sub_f32 v62, v62, v28
    v_sub_f32 v63, v63, v28
    v_sub_f32 v64, v64, v28
    v_sub_f32 v65, v65, v28
    v_sub_f32 v66, v66, v28
    v_sub_f32 v67, v67, v28
    v_sub_f32 v68, v68, v28
    v_sub_f32 v69, v69, v28
    v_sub_f32 v70, v70, v28
    v_sub_f32 v71, v71, v28
    v_sub_f32 v72, v72, v28
    v_sub_f32 v73, v73, v28
    v_sub_f32 v74, v74, v28
    v_sub_f32 v75, v75, v28
    v_sub_f32 v76, v76, v28
    v_sub_f32 v77, v77, v28
    v_sub_f32 v78, v78, v28
    v_sub_f32 v79, v79, v28
    v_mul_f32 v80, v80, v29
    v_mul_f32 v81, v81, v29
    v_mul_f32 v82, v82, v29
    v_mul_f32 v83, v83, v29
    v_mul_f32 v84, v84, v29
    v_mul_f32 v85, v85, v29
    v_mul_f32 v86, v86, v29
    v_mul_f32 v87, v87, v29
    v_mul_f32 v88, v88, v29
    v_mul_f32 v89, v89, v29
    v_mul_f32 v90, v90, v29
    v_mul_f32 v91, v91, v29
    v_mul_f32 v92, v92, v29
    v_mul_f32 v93, v93, v29
    v_mul_f32 v94, v94, v29
    v_mul_f32 v95, v95, v29
    v_mul_f32 v96, v96, v29
    v_mul_f32 v97, v97, v29
    v_mul_f32 v98, v98, v29
    v_mul_f32 v99, v99, v29
    v_mul_f32 v100, v100, v29
    v_mul_f32 v101, v101, v29
    v_mul_f32 v102, v102, v29
    v_mul_f32 v103, v103, v29
    v_mul_f32 v104, v104, v29
    v_mul_f32 v105, v105, v29
    v_mul_f32 v106, v106, v29
    v_mul_f32 v107, v107, v29
    v_mul_f32 v108, v108, v29
    v_mul_f32 v109, v109, v29
    v_mul_f32 v110, v110, v29
    v_mul_f32 v111, v111, v29
    v_mul_f32 v112, v112, v29
    v_mul_f32 v113, v113, v29
    v_mul_f32 v114, v114, v29
    v_mul_f32 v115, v115, v29
    v_mul_f32 v116, v116, v29
    v_mul_f32 v117, v117, v29
    v_mul_f32 v118, v118, v29
    v_mul_f32 v119, v119, v29
    v_mul_f32 v120, v120, v29
    v_mul_f32 v121, v121, v29
    v_mul_f32 v122, v122, v29
    v_mul_f32 v123, v123, v29
    v_mul_f32 v124, v124, v29
    v_mul_f32 v125, v125, v29
    v_mul_f32 v126, v126, v29
    v_mul_f32 v127, v127, v29
    v_mul_f32 v128, v128, v29
    v_mul_f32 v129, v129, v29
    v_mul_f32 v130, v130, v29
    v_mul_f32 v131, v131, v29
    v_mul_f32 v132, v132, v29
    v_mul_f32 v133, v133, v29
    v_mul_f32 v134, v134, v29
    v_mul_f32 v135, v135, v29
    v_mul_f32 v136, v136, v29
    v_mul_f32 v137, v137, v29
    v_mul_f32 v138, v138, v29
    v_mul_f32 v139, v139, v29
    v_mul_f32 v140, v140, v29
    v_mul_f32 v141, v141, v29
    v_mul_f32 v142, v142, v29
    v_mul_f32 v143, v143, v29
    v_mul_f32 v21, v21, v29
    v_exp_f32 v24, v64
    v_exp_f32 v25, v65
    v_exp_f32 v26, v66
    v_add_f32 v22, v24, v25
    v_exp_f32 v27, v67
    v_cvt_pk_bf16_f32 v40, v24, v25
    v_exp_f32 v24, v68
    v_add_f32 v22, v22, v26
    v_add_f32 v22, v22, v27
    v_exp_f32 v25, v69
    v_cvt_pk_bf16_f32 v41, v26, v27
    v_exp_f32 v26, v70
    v_add_f32 v22, v22, v24
    v_add_f32 v22, v22, v25
    v_exp_f32 v27, v71
    v_cvt_pk_bf16_f32 v42, v24, v25
    v_exp_f32 v24, v72
    v_add_f32 v22, v22, v26
    v_add_f32 v22, v22, v27
    v_exp_f32 v25, v73
    v_cvt_pk_bf16_f32 v43, v26, v27
    v_exp_f32 v26, v74
    v_add_f32 v22, v22, v24
    v_add_f32 v22, v22, v25
    v_exp_f32 v27, v75
    v_cvt_pk_bf16_f32 v44, v24, v25
    v_exp_f32 v24, v76
    v_add_f32 v22, v22, v26
    v_add_f32 v22, v22, v27
    v_exp_f32 v25, v77
    v_cvt_pk_bf16_f32 v45, v26, v27
    v_exp_f32 v26, v78
    v_add_f32 v22, v22, v24
    v_add_f32 v22, v22, v25
    v_exp_f32 v27, v79
    v_cvt_pk_bf16_f32 v46, v24, v25
    v_add_f32 v22, v22, v26
    v_add_f32 v22, v22, v27
    v_cvt_pk_bf16_f32 v47, v26, v27
    s_nop 1
    s_cmp_eq_u32 s36, 1
    s_cbranch_scc1 L_b1
    s_cmp_eq_u32 s36, 3
    s_cbranch_scc1 L_b3
    s_cmp_eq_u32 s36, 5
    s_cbranch_scc1 L_b5
    s_cmp_eq_u32 s36, 7
    s_cbranch_scc1 L_b7
    s_endpgm
.section .rodata,"a"
.p2align 6
.amdhsa_kernel standalone__gqa_softmax__near_ridge_kernel
  .amdhsa_next_free_vgpr 256
  .amdhsa_next_free_sgpr 102
  .amdhsa_accum_offset 160
  .amdhsa_group_segment_fixed_size 0
  .amdhsa_kernarg_size 48
  .amdhsa_user_sgpr_count 2
  .amdhsa_user_sgpr_kernarg_segment_ptr 1
  .amdhsa_system_sgpr_workgroup_id_x 1
  .amdhsa_float_denorm_mode_32 3
.end_amdhsa_kernel
```
